```python
import torch

def _softmax(x, axis=-1):
    return torch.softmax(x, dim=axis)

def _gelu(x):
    return torch.nn.functional.gelu(x, approximate='tanh')

def _silu(x):
    return torch.nn.functional.silu(x)

def _sigmoid(x):
    return torch.sigmoid(x)

def _layernorm(x, axis=-1, eps=1e-05):
    m = x.mean(dim=axis, keepdim=True)
    v = x.var(dim=axis, keepdim=True, unbiased=False)
    return (x - m) / torch.sqrt(v + eps)

def _scatter_add(tgt, idx, src, axis=0):
    return tgt.clone().index_add_(axis, idx, src)

def _segment_sum(src, seg, n):
    out = torch.zeros((n,) + src.shape[1:], dtype=src.dtype)
    return out.index_add_(0, seg, src)

def _pad(x, pw):
    flat = tuple((v for pair in reversed(pw) for v in pair))
    return torch.nn.functional.pad(x, flat)
kernel_name = 'standalone__tree_speculative_verify_tree_attention_over_candidate_token_tree__decode'

def setup_inputs():

    _w = lambda a: (lambda t: t.to(torch.bfloat16) if t.is_floating_point() else t)(torch.as_tensor(a))
    B, Hq, Hkv, T, C, D = (1, 32, 16, 1, 32768, 128)
    tree_mask = torch.zeros((B, T, T), dtype=float)
    for b in range(B):
        parent = torch.zeros(T, dtype=torch.int64)
        for i in range(1, T):
            parent[i] = int(torch.randint(0, i, (1,)).item())
        for i in range(T):
            j = i
            tree_mask[b, i, j] = 1.0
            while j > 0:
                j = parent[j]
                tree_mask[b, i, j] = 1.0
    return {'q': _w((lambda *s: torch.randn(*s, dtype=torch.bfloat16) * 0.8)(B, Hq, T, D)), 'k_cache': _w((lambda *s: torch.randn(*s, dtype=torch.bfloat16) * 0.8)(B, Hkv, C, D)), 'v_cache': _w((lambda *s: torch.randn(*s, dtype=torch.bfloat16) * 0.05)(B, Hkv, C, D)), 'k_tree': _w((lambda *s: torch.randn(*s, dtype=torch.bfloat16) * 0.8)(B, Hkv, T, D)), 'v_tree': _w((lambda *s: torch.randn(*s, dtype=torch.bfloat16) * 0.05)(B, Hkv, T, D)), 'tree_mask': _w(tree_mask)}

def reference(q, k_cache, v_cache, k_tree, v_tree, tree_mask):
    B, Hq, T, D = q.shape
    Hkv, C = (k_cache.shape[1], k_cache.shape[2])
    rep = Hq // Hkv
    kc = (lambda x, n, axis: torch.repeat_interleave(x, n, dim=axis))(k_cache, rep, axis=1)
    vc = (lambda x, n, axis: torch.repeat_interleave(x, n, dim=axis))(v_cache, rep, axis=1)
    kt = (lambda x, n, axis: torch.repeat_interleave(x, n, dim=axis))(k_tree, rep, axis=1)
    vt = (lambda x, n, axis: torch.repeat_interleave(x, n, dim=axis))(v_tree, rep, axis=1)
    k = torch.concatenate([kc, kt], axis=2)
    v = torch.concatenate([vc, vt], axis=2)
    scale = D ** (-0.5)
    scores = torch.einsum('bhqd,bhkd->bhqk', q, k) * scale
    ctx_mask = torch.ones((B, 1, T, C), dtype=scores.dtype)
    tm = tree_mask[:, None, :, :].clone()
    full_mask = torch.concatenate([ctx_mask, tm], axis=-1)
    scores = scores + (1.0 - full_mask) * -1000000000.0
    p = _softmax(scores, axis=-1)
    return torch.einsum('bhqk,bhkd->bhqd', p, v)
```

```asm
; @launch grid=(256,1,1) block=(256,1,1) lds=16896
.amdgcn_target "amdgcn-amd-amdhsa--gfx950"
.text
.globl standalone__tree_speculative_verify_tree_attention_over_candidate_token_tree__decode_kernel
.p2align 8
.type standalone__tree_speculative_verify_tree_attention_over_candidate_token_tree__decode_kernel,@function
standalone__tree_speculative_verify_tree_attention_over_candidate_token_tree__decode_kernel:
    s_load_dwordx16 s[4:19], s[0:1], 0
    s_load_dwordx2 s[20:21], s[0:1], 64
    s_memrealtime s[54:55]
    v_lshrrev_b32 v15, 6, v0
    v_and_b32 v1, 63, v0
    v_readfirstlane_b32 s3, v15
    s_cmp_ge_u32 s2, 256
    s_cbranch_scc1 L_end
    s_and_b32 s22, s2, 15
    s_lshr_b32 s23, s2, 4
    v_lshrrev_b32 v42, 4, v1
    v_and_b32 v43, 3, v1
    v_lshlrev_b32 v42, 6, v42
    v_lshl_add_u32 v42, v43, 4, v42
    v_bfe_u32 v43, v1, 2, 2
    v_lshl_add_u32 v2, v43, 8, v42
    s_bfe_u32 s44, s23, 0x10000
    s_lshl_b32 s44, s44, 16
    s_bfe_u32 s36, s23, 0x10001
    s_lshl_b32 s36, s36, 18
    s_or_b32 s44, s44, s36
    s_bfe_u32 s36, s23, 0x20002
    s_lshl_b32 s36, s36, 20
    s_or_b32 s44, s44, s36
    s_bfe_u32 s36, s3, 0x20000
    s_lshl_b32 s36, s36, 12
    s_or_b32 s44, s44, s36
    s_lshl_b32 s34, s22, 23
    s_lshl_b32 s38, s22, 9
    s_mov_b32 s50, 0x800000
    s_mov_b32 s51, 0x20000
    s_mov_b32 s35, s44
    s_mul_i32 s46, s22, 4
    s_lshr_b32 s47, s23, 1
    s_mul_i32 s47, s47, 8
    s_add_u32 s46, s46, s47
    s_bfe_u32 s37, s46, 0x10002
    s_lshl_b32 s37, s37, 17
    s_bfe_u32 s47, s46, 0x10003
    s_lshl_b32 s47, s47, 19
    s_or_b32 s37, s37, s47
    s_bfe_u32 s47, s46, 0x10004
    s_lshl_b32 s47, s47, 22
    s_or_b32 s37, s37, s47
    s_or_b32 s44, s44, s37
    s_or_b32 s45, s44, 0x4000
    v_bfe_u32 v43, v1, 3, 1
    v_lshl_add_u32 v41, v43, 8, v42
    v_add_u32 v41, s38, v41
    s_lshl_b32 s46, s22, 15
    s_lshl_b32 s47, s23, 11
    s_add_u32 s46, s46, s47
    v_lshlrev_b32 v82, 5, v1
    v_add_u32 v82, s46, v82
    v_mov_b32 v83, 0
    s_lshl_b32 s33, s22, 8
    v_add_u32 v42, s33, v42
    v_and_b32 v36, 15, v1
    v_bfe_u32 v43, v1, 4, 1
    v_lshlrev_b32 v36, 4, v36
    v_lshl_add_u32 v36, v43, 3, v36
    v_add_u32 v43, s33, v36
    s_lshl_b32 s33, s22, 2
    v_mov_b32 v91, s33
    s_getreg_b32 s58, hwreg(HW_REG_XCC_ID, 0, 4)
    s_lshl_b32 s36, s23, 2
    s_add_u32 s36, s36, s3
    s_waitcnt lgkmcnt(0)
    s_add_u32 s32, s54, 112
    s_cmp_lg_u32 s36, 1
    s_mov_b32 s24, s54
    s_cbranch_scc0 L_owner
L_start:
    s_cmp_lg_u32 s3, 0
    s_cbranch_scc1 L_nowarm
    global_load_dword v80, v82, s[20:21]
    global_load_dword v81, v83, s[16:17]
L_nowarm:
    s_add_u32 s48, s6, s34
    s_addc_u32 s49, s7, 0
    buffer_load_dwordx4 v[48:51], v2, s[48:51], s44 offen nt
    global_load_dwordx4 v[4:7], v41, s[4:5]
    buffer_load_dwordx4 v[52:55], v2, s[48:51], s44 offen offset:1024 nt
    buffer_load_dwordx4 v[56:59], v2, s[48:51], s44 offen offset:2048 nt
    buffer_load_dwordx4 v[60:63], v2, s[48:51], s44 offen offset:3072 nt
    s_barrier
    buffer_load_dwordx4 v[64:67], v2, s[48:51], s45 offen nt
    s_add_u32 s28, s8, s34
    s_addc_u32 s29, s9, 0
    s_or_b32 s46, s44, 0x8000
    s_or_b32 s47, s44, 0xc000
    s_or_b32 s37, s37, 0xc000
    v_lshlrev_b32 v3, 4, v1
    v_mov_b32 v88, v2
    s_lshl_b32 s34, s3, 12
    v_lshrrev_b32 v89, 3, v1
    v_lshlrev_b32 v89, 4, v89
    v_add_u32 v89, s34, v89
    v_lshlrev_b32 v15, 3, v1
    v_add_u32 v94, s34, v3
    v_add_u32 v95, s34, v15
    v_and_b32 v40, 1, v1
    v_lshlrev_b32 v40, 4, v40
    v_mov_b32 v41, 0xffff
    v_lshlrev_b32 v41, v40, v41
    v_bfe_u32 v40, v1, 1, 2
    v_cmp_eq_u32 vcc, 0, v40
    s_nop 1
    v_cndmask_b32 v8, 0, v41, vcc
    v_cmp_eq_u32 vcc, 1, v40
    s_nop 1
    v_cndmask_b32 v9, 0, v41, vcc
    v_cmp_eq_u32 vcc, 2, v40
    s_nop 1
    v_cndmask_b32 v10, 0, v41, vcc
    v_cmp_eq_u32 vcc, 3, v40
    s_nop 1
    v_cndmask_b32 v11, 0, v41, vcc
    v_and_b32 v99, 15, v1
    v_lshlrev_b32 v99, 4, v99
    v_bfe_u32 v40, v1, 4, 1
    v_lshl_add_u32 v96, v40, 2, v99
    v_lshrrev_b32 v40, 5, v1
    v_lshl_add_u32 v96, v40, 1, v96
    s_lshr_b32 s34, s3, 1
    s_lshl_b32 s34, s34, 8
    s_add_u32 s38, s38, s34
    s_and_b32 s34, s3, 1
    s_lshl_b32 s34, s34, 3
    s_add_u32 s38, s38, s34
    v_add_u32 v96, s38, v96
    v_lshrrev_b32 v40, 4, v1
    v_lshl_add_u32 v99, v40, 11, v99
    s_lshl_b32 s34, s3, 8
    v_add_u32 v99, s34, v99
    v_mov_b32 v98, 16640
    v_mov_b32 v12, 0x3e0293ee
    s_mov_b32 s39, 16
    s_mov_b32 s52, 0x01010101
    s_mov_b32 s53, 0x01010101
    s_lshl_b32 s34, s22, 15
    s_mov_b32 s42, 0x8000
    s_mov_b32 s43, 0x20000
    s_lshl_b32 s54, s23, 11
    s_mov_b32 s59, 0x40000
    s_add_u32 s40, s20, s34
    s_addc_u32 s41, s21, 0
    s_cmp_lg_u32 s36, 1
    s_cbranch_scc0 L_tree
    v_mov_b32 v13, 0xff7fffff
    v_mov_b32 v16, 0
    v_mov_b32 v17, 0
    v_mov_b32 v18, 0
    v_mov_b32 v19, 0
L_treedone:
    v_mov_b32 v90, v13
    s_waitcnt vmcnt(4)
    buffer_load_dwordx4 v[68:71], v2, s[48:51], s45 offen offset:1024 nt
    s_waitcnt vmcnt(4)
    buffer_load_dwordx4 v[72:75], v2, s[48:51], s45 offen offset:2048 nt
    s_waitcnt vmcnt(4)
    buffer_load_dwordx4 v[76:79], v2, s[48:51], s45 offen offset:3072 nt
L_k:
    s_waitcnt lgkmcnt(0)
    s_cmp_lg_u32 s39, 1
    s_cbranch_scc1 L_k1
    s_mov_b64 s[48:49], s[28:29]
    v_mov_b32 v88, v3
    s_load_dword s56, s[18:19], s33
L_k1:
    s_sub_u32 s26, s24, s32
    s_add_u32 s32, s32, 108
    s_cmp_gt_i32 s26, 60
    s_cselect_b64 vcc, -1, 0
    s_cmp_gt_i32 s26, 0
    s_cbranch_scc1 L_kd0
    s_waitcnt vmcnt(4)
L_kd0:
    s_cbranch_vccnz L_kx0
    s_waitcnt vmcnt(5)
L_kx0:
    s_waitcnt vmcnt(7)
    v_mfma_f32_16x16x32_bf16 v[20:23], v[48:51], v[4:7], 0
    buffer_load_dwordx4 v[48:51], v88, s[48:51], s46 offen nt
    s_cbranch_scc1 L_kd1
    s_waitcnt vmcnt(4)
L_kd1:
    s_cbranch_vccnz L_kx1
    s_waitcnt vmcnt(5)
L_kx1:
    s_waitcnt vmcnt(7)
    v_mfma_f32_16x16x32_bf16 v[24:27], v[52:55], v[4:7], 0
    buffer_load_dwordx4 v[52:55], v88, s[48:51], s46 offen offset:1024 nt
    s_cbranch_scc1 L_kd2
    s_waitcnt vmcnt(4)
L_kd2:
    s_cbranch_vccnz L_kx2
    s_waitcnt vmcnt(5)
L_kx2:
    s_waitcnt vmcnt(7)
    v_mfma_f32_16x16x32_bf16 v[28:31], v[56:59], v[4:7], 0
    buffer_load_dwordx4 v[56:59], v88, s[48:51], s46 offen offset:2048 nt
    s_cbranch_scc1 L_kd3
    s_waitcnt vmcnt(5)
L_kd3:
    s_cbranch_vccnz L_kx3
    s_waitcnt vmcnt(5)
L_kx3:
    s_waitcnt vmcnt(7)
    v_mfma_f32_16x16x32_bf16 v[32:35], v[60:63], v[4:7], 0
    buffer_load_dwordx4 v[60:63], v88, s[48:51], s46 offen offset:3072 nt
    s_nop 1
    v_mul_f32_dpp v36, v20, v12 quad_perm:[0,0,0,0] row_mask:0xf bank_mask:0xf
    v_mul_f32_dpp v37, v24, v12 quad_perm:[0,0,0,0] row_mask:0xf bank_mask:0xf
    v_mul_f32_dpp v38, v28, v12 quad_perm:[0,0,0,0] row_mask:0xf bank_mask:0xf
    v_fmac_f32_dpp v36, v21, v12 quad_perm:[1,1,1,1] row_mask:0xf bank_mask:0xf
    v_fmac_f32_dpp v37, v25, v12 quad_perm:[1,1,1,1] row_mask:0xf bank_mask:0xf
    v_mul_f32_dpp v39, v32, v12 quad_perm:[0,0,0,0] row_mask:0xf bank_mask:0xf
    v_fmac_f32_dpp v38, v29, v12 quad_perm:[1,1,1,1] row_mask:0xf bank_mask:0xf
    v_fmac_f32_dpp v36, v22, v12 quad_perm:[2,2,2,2] row_mask:0xf bank_mask:0xf
    v_fmac_f32_dpp v37, v26, v12 quad_perm:[2,2,2,2] row_mask:0xf bank_mask:0xf
    v_fmac_f32_dpp v39, v33, v12 quad_perm:[1,1,1,1] row_mask:0xf bank_mask:0xf
    v_fmac_f32_dpp v38, v30, v12 quad_perm:[2,2,2,2] row_mask:0xf bank_mask:0xf
    v_fmac_f32_dpp v36, v23, v12 quad_perm:[3,3,3,3] row_mask:0xf bank_mask:0xf
    v_fmac_f32_dpp v37, v27, v12 quad_perm:[3,3,3,3] row_mask:0xf bank_mask:0xf
    v_fmac_f32_dpp v39, v34, v12 quad_perm:[2,2,2,2] row_mask:0xf bank_mask:0xf
    v_fmac_f32_dpp v38, v31, v12 quad_perm:[3,3,3,3] row_mask:0xf bank_mask:0xf
    v_max3_f32 v13, v36, v37, v13
    v_fmac_f32_dpp v39, v35, v12 quad_perm:[3,3,3,3] row_mask:0xf bank_mask:0xf
    v_max3_f32 v13, v38, v39, v13
    s_mov_b64 exec, s[52:53]
    ds_write_b128 v89, v[36:39]
    s_mov_b64 exec, -1
    s_memrealtime s[24:25]
    s_cbranch_scc1 L_kd4
    s_waitcnt vmcnt(4)
L_kd4:
    s_cbranch_vccnz L_kx4
    s_waitcnt vmcnt(5)
L_kx4:
    s_waitcnt vmcnt(7)
    v_mfma_f32_16x16x32_bf16 v[20:23], v[64:67], v[4:7], 0
    buffer_load_dwordx4 v[64:67], v88, s[48:51], s47 offen nt
    s_cbranch_scc1 L_kd5
    s_waitcnt vmcnt(4)
L_kd5:
    s_cbranch_vccnz L_kx5
    s_waitcnt vmcnt(5)
L_kx5:
    s_waitcnt vmcnt(7)
    v_mfma_f32_16x16x32_bf16 v[24:27], v[68:71], v[4:7], 0
    buffer_load_dwordx4 v[68:71], v88, s[48:51], s47 offen offset:1024 nt
    s_cbranch_scc1 L_kd6
    s_waitcnt vmcnt(4)
L_kd6:
    s_cbranch_vccnz L_kx6
    s_waitcnt vmcnt(5)
L_kx6:
    s_waitcnt vmcnt(7)
    v_mfma_f32_16x16x32_bf16 v[28:31], v[72:75], v[4:7], 0
    buffer_load_dwordx4 v[72:75], v88, s[48:51], s47 offen offset:2048 nt
    s_cbranch_scc1 L_kd7
    s_waitcnt vmcnt(5)
L_kd7:
    s_cbranch_vccnz L_kx7
    s_waitcnt vmcnt(5)
L_kx7:
    s_waitcnt vmcnt(7)
    v_mfma_f32_16x16x32_bf16 v[32:35], v[76:79], v[4:7], 0
    buffer_load_dwordx4 v[76:79], v88, s[48:51], s47 offen offset:3072 nt
    s_nop 1
    v_mul_f32_dpp v36, v20, v12 quad_perm:[0,0,0,0] row_mask:0xf bank_mask:0xf
    v_mul_f32_dpp v37, v24, v12 quad_perm:[0,0,0,0] row_mask:0xf bank_mask:0xf
    v_mul_f32_dpp v38, v28, v12 quad_perm:[0,0,0,0] row_mask:0xf bank_mask:0xf
    v_fmac_f32_dpp v36, v21, v12 quad_perm:[1,1,1,1] row_mask:0xf bank_mask:0xf
    v_fmac_f32_dpp v37, v25, v12 quad_perm:[1,1,1,1] row_mask:0xf bank_mask:0xf
    v_mul_f32_dpp v39, v32, v12 quad_perm:[0,0,0,0] row_mask:0xf bank_mask:0xf
    v_fmac_f32_dpp v38, v29, v12 quad_perm:[1,1,1,1] row_mask:0xf bank_mask:0xf
    v_fmac_f32_dpp v36, v22, v12 quad_perm:[2,2,2,2] row_mask:0xf bank_mask:0xf
    v_fmac_f32_dpp v37, v26, v12 quad_perm:[2,2,2,2] row_mask:0xf bank_mask:0xf
    v_fmac_f32_dpp v39, v33, v12 quad_perm:[1,1,1,1] row_mask:0xf bank_mask:0xf
    v_fmac_f32_dpp v38, v30, v12 quad_perm:[2,2,2,2] row_mask:0xf bank_mask:0xf
    v_fmac_f32_dpp v36, v23, v12 quad_perm:[3,3,3,3] row_mask:0xf bank_mask:0xf
    v_fmac_f32_dpp v37, v27, v12 quad_perm:[3,3,3,3] row_mask:0xf bank_mask:0xf
    v_fmac_f32_dpp v39, v34, v12 quad_perm:[2,2,2,2] row_mask:0xf bank_mask:0xf
    v_fmac_f32_dpp v38, v31, v12 quad_perm:[3,3,3,3] row_mask:0xf bank_mask:0xf
    v_max3_f32 v13, v36, v37, v13
    v_fmac_f32_dpp v39, v35, v12 quad_perm:[3,3,3,3] row_mask:0xf bank_mask:0xf
    v_max3_f32 v13, v38, v39, v13
    s_mov_b64 exec, s[52:53]
    ds_write_b128 v89, v[36:39] offset:128
    s_mov_b64 exec, -1
    v_add_u32 v89, 0x100, v89
    s_or_b32 s37, s37, 0xffb53fff
    s_add_u32 s37, s37, 1
    s_and_b32 s37, s37, 0x4ac000
    s_or_b32 s46, s37, s35
    s_or_b32 s37, s37, 0xffb53fff
    s_add_u32 s37, s37, 1
    s_and_b32 s37, s37, 0x4ac000
    s_or_b32 s47, s37, s35
    s_sub_u32 s39, s39, 1
    s_cmp_lg_u32 s39, 0
    s_cbranch_scc1 L_k
    v_subrev_u32 v89, 0x1000, v89
    v_mov_b32 v43, v13
    s_waitcnt lgkmcnt(0)
    ds_read_b128 v[80:83], v89
    ds_read_b128 v[84:87], v89 offset:128
    v_permlane32_swap_b32 v43, v13
    v_max_f32 v13, v43, v13
    v_mov_b32 v43, v13
    v_cmp_gt_u32 vcc, 16, v1
    s_mov_b32 s39, 16
    v_permlane16_swap_b32 v43, v13
    v_max_f32 v13, v43, v13
    v_sub_f32 v40, v90, v13
    v_mov_b32 v92, v13
    v_exp_f32 v40, v40
    s_nop 0
    v_mov_b32 v41, v40
    v_cndmask_b32 v14, 0, v40, vcc
    v_mov_b32_dpp v92, v13 row_ror:8 row_mask:0x3 bank_mask:0xc
    v_mov_b32_dpp v41, v40 row_ror:8 row_mask:0x3 bank_mask:0xc
    s_nop 0
    v_mov_b32_dpp v92, v13 row_ror:8 row_mask:0xc bank_mask:0x3
    v_mov_b32_dpp v41, v40 row_ror:8 row_mask:0xc bank_mask:0x3
    v_mul_f32 v16, v16, v41
    v_mul_f32 v17, v17, v41
    v_mul_f32 v18, v18, v41
    v_mul_f32 v19, v19, v41
L_v:
    s_cmp_eq_u32 s39, 1
    s_cselect_b32 s50, 0, s50
    s_cbranch_scc1 L_elect
L_v0:
    s_cmp_le_u32 s39, 5
    s_cselect_b32 s27, 16, 0
    s_sub_u32 s32, s32, s27
    s_waitcnt lgkmcnt(0)
    s_sub_u32 s26, s24, s32
    s_add_u32 s32, s32, 108
    s_cmp_gt_i32 s26, 60
    s_cselect_b64 vcc, -1, 0
    s_cmp_gt_i32 s26, 0
    s_waitcnt lgkmcnt(1)
    v_sub_f32 v36, v80, v13
    v_sub_f32 v37, v81, v13
    v_sub_f32 v38, v82, v13
    v_sub_f32 v39, v83, v13
    ds_read_b128 v[80:83], v89 offset:256
    v_exp_f32 v36, v36
    v_exp_f32 v37, v37
    v_exp_f32 v38, v38
    v_exp_f32 v39, v39
    v_add_f32 v14, v14, v36
    v_cvt_pk_bf16_f32 v44, v36, v36
    v_cvt_pk_bf16_f32 v45, v37, v37
    v_cvt_pk_bf16_f32 v46, v38, v38
    v_cvt_pk_bf16_f32 v47, v39, v39
    v_add_f32 v42, v37, v38
    v_add_f32 v14, v14, v39
    v_and_b32 v20, v44, v8
    v_and_b32 v21, v44, v9
    v_and_b32 v22, v44, v10
    v_and_b32 v23, v44, v11
    v_and_b32 v24, v45, v8
    v_and_b32 v25, v45, v9
    v_and_b32 v26, v45, v10
    v_and_b32 v27, v45, v11
    v_and_b32 v28, v46, v8
    v_and_b32 v29, v46, v9
    v_and_b32 v30, v46, v10
    v_and_b32 v31, v46, v11
    v_and_b32 v32, v47, v8
    v_and_b32 v33, v47, v9
    v_and_b32 v34, v47, v10
    v_and_b32 v35, v47, v11
    v_add_f32 v14, v14, v42
    s_cbranch_scc1 L_vd0
    s_waitcnt vmcnt(4)
L_vd0:
    s_cbranch_vccnz L_vx0
    s_waitcnt vmcnt(5)
L_vx0:
    s_waitcnt vmcnt(7)
    v_mfma_f32_16x16x32_bf16 v[16:19], v[20:23], v[48:51], v[16:19]
    buffer_load_dwordx4 v[48:51], v3, s[48:51], s46 offen nt
    s_cbranch_scc1 L_vd1
    s_waitcnt vmcnt(4)
L_vd1:
    s_cbranch_vccnz L_vx1
    s_waitcnt vmcnt(5)
L_vx1:
    s_waitcnt vmcnt(7)
    v_mfma_f32_16x16x32_bf16 v[16:19], v[24:27], v[52:55], v[16:19]
    buffer_load_dwordx4 v[52:55], v3, s[48:51], s46 offen offset:1024 nt
    s_cbranch_scc1 L_vd2
    s_waitcnt vmcnt(4)
L_vd2:
    s_cbranch_vccnz L_vx2
    s_waitcnt vmcnt(5)
L_vx2:
    s_waitcnt vmcnt(7)
    v_mfma_f32_16x16x32_bf16 v[16:19], v[28:31], v[56:59], v[16:19]
    buffer_load_dwordx4 v[56:59], v3, s[48:51], s46 offen offset:2048 nt
    s_cbranch_scc1 L_vd3
    s_waitcnt vmcnt(5)
L_vd3:
    s_cbranch_vccnz L_vx3
    s_waitcnt vmcnt(5)
L_vx3:
    s_waitcnt vmcnt(7)
    v_mfma_f32_16x16x32_bf16 v[16:19], v[32:35], v[60:63], v[16:19]
    buffer_load_dwordx4 v[60:63], v3, s[48:51], s46 offen offset:3072 nt
    s_waitcnt lgkmcnt(1)
    v_sub_f32 v36, v84, v13
    v_sub_f32 v37, v85, v13
    v_sub_f32 v38, v86, v13
    v_sub_f32 v39, v87, v13
    ds_read_b128 v[84:87], v89 offset:384
    v_exp_f32 v36, v36
    v_exp_f32 v37, v37
    v_exp_f32 v38, v38
    v_exp_f32 v39, v39
    v_add_f32 v14, v14, v36
    v_cvt_pk_bf16_f32 v44, v36, v36
    v_cvt_pk_bf16_f32 v45, v37, v37
    v_cvt_pk_bf16_f32 v46, v38, v38
    v_cvt_pk_bf16_f32 v47, v39, v39
    v_add_f32 v42, v37, v38
    v_add_f32 v14, v14, v39
    v_and_b32 v20, v44, v8
    v_and_b32 v21, v44, v9
    v_and_b32 v22, v44, v10
    v_and_b32 v23, v44, v11
    v_and_b32 v24, v45, v8
    v_and_b32 v25, v45, v9
    v_and_b32 v26, v45, v10
    v_and_b32 v27, v45, v11
    v_and_b32 v28, v46, v8
    v_and_b32 v29, v46, v9
    v_and_b32 v30, v46, v10
    v_and_b32 v31, v46, v11
    v_and_b32 v32, v47, v8
    v_and_b32 v33, v47, v9
    v_and_b32 v34, v47, v10
    v_and_b32 v35, v47, v11
    v_add_f32 v14, v14, v42
    s_memrealtime s[24:25]
    s_cmp_lg_u32 s39, 1
    s_cbranch_scc1 L_v1
    v_mov_b32 v43, v14
    s_nop 1
    v_permlane32_swap_b32 v43, v14
    v_add_f32 v14, v43, v14
    v_mov_b32 v43, v14
    s_nop 1
    v_permlane16_swap_b32 v43, v14
    v_add_f32 v14, v43, v14
    v_mov_b32 v93, v14
    s_nop 1
    v_mov_b32_dpp v93, v14 row_ror:8 row_mask:0x3 bank_mask:0xc
    s_nop 1
    v_mov_b32_dpp v93, v14 row_ror:8 row_mask:0xc bank_mask:0x3
    ds_write_b64 v95, v[92:93] offset:1024
L_v1:
    s_cmp_gt_i32 s26, 0
    s_cbranch_scc1 L_vd4
    s_waitcnt vmcnt(4)
L_vd4:
    s_cbranch_vccnz L_vx4
    s_waitcnt vmcnt(5)
L_vx4:
    s_waitcnt vmcnt(7)
    v_mfma_f32_16x16x32_bf16 v[16:19], v[20:23], v[64:67], v[16:19]
    buffer_load_dwordx4 v[64:67], v3, s[48:51], s47 offen nt
    s_cbranch_scc1 L_vd5
    s_waitcnt vmcnt(4)
L_vd5:
    s_cbranch_vccnz L_vx5
    s_waitcnt vmcnt(5)
L_vx5:
    s_waitcnt vmcnt(7)
    v_mfma_f32_16x16x32_bf16 v[16:19], v[24:27], v[68:71], v[16:19]
    buffer_load_dwordx4 v[68:71], v3, s[48:51], s47 offen offset:1024 nt
    s_cbranch_scc1 L_vd6
    s_waitcnt vmcnt(4)
L_vd6:
    s_cbranch_vccnz L_vx6
    s_waitcnt vmcnt(5)
L_vx6:
    s_waitcnt vmcnt(7)
    v_mfma_f32_16x16x32_bf16 v[16:19], v[28:31], v[72:75], v[16:19]
    buffer_load_dwordx4 v[72:75], v3, s[48:51], s47 offen offset:2048 nt
    s_cbranch_scc1 L_vd7
    s_waitcnt vmcnt(5)
L_vd7:
    s_cbranch_vccnz L_vx7
    s_waitcnt vmcnt(5)
L_vx7:
    s_waitcnt vmcnt(7)
    v_mfma_f32_16x16x32_bf16 v[16:19], v[32:35], v[76:79], v[16:19]
    buffer_load_dwordx4 v[76:79], v3, s[48:51], s47 offen offset:3072 nt
    v_add_u32 v89, 0x100, v89
    s_or_b32 s37, s37, 0xffb53fff
    s_add_u32 s37, s37, 1
    s_and_b32 s37, s37, 0x4ac000
    s_or_b32 s46, s37, s35
    s_or_b32 s37, s37, 0xffb53fff
    s_add_u32 s37, s37, 1
    s_and_b32 s37, s37, 0x4ac000
    s_or_b32 s47, s37, s35
    s_sub_u32 s39, s39, 1
    s_cmp_lg_u32 s39, 0
    s_cbranch_scc1 L_v
    ds_write_b128 v94, v[16:19]
    s_cmp_lg_u32 s3, 1
    s_cbranch_scc1 L_novote
    s_mov_b64 exec, 1
    s_waitcnt vmcnt(8)
    ds_write_b32 v98, v97
    s_mov_b64 exec, -1
L_novote:
    v_mov_b32 v11, v7
    s_cmp_eq_u32 s3, 0
    s_waitcnt lgkmcnt(0)
    s_barrier
    ds_read_b32 v12, v98
    s_cbranch_scc0 L_other
    ds_read_b64 v[20:21], v15 offset:1024
    ds_read_b64 v[22:23], v15 offset:5120
    ds_read_b64 v[24:25], v15 offset:9216
    ds_read_b64 v[26:27], v15 offset:13312
    ds_read_b128 v[28:31], v3 offset:0
    ds_read_b128 v[32:35], v3 offset:4096
    ds_read_b128 v[36:39], v3 offset:8192
    ds_read_b128 v[40:43], v3 offset:12288
    s_cmp_lg_u32 s55, 0
    s_waitcnt lgkmcnt(4)
    v_max_f32 v9, v20, v22
    v_max3_f32 v9, v24, v26, v9
    v_sub_f32 v20, v20, v9
    v_sub_f32 v22, v22, v9
    v_sub_f32 v24, v24, v9
    v_sub_f32 v26, v26, v9
    v_exp_f32 v20, v20
    v_exp_f32 v22, v22
    v_exp_f32 v24, v24
    v_exp_f32 v26, v26
    s_waitcnt lgkmcnt(0)
    v_mul_f32 v10, v20, v21
    v_mul_f32 v4, v20, v28
    v_mul_f32 v5, v20, v29
    v_mul_f32 v6, v20, v30
    v_mul_f32 v8, v20, v31
    v_fmac_f32 v10, v22, v23
    v_fmac_f32 v4, v22, v32
    v_fmac_f32 v5, v22, v33
    v_fmac_f32 v6, v22, v34
    v_fmac_f32 v8, v22, v35
    v_fmac_f32 v10, v24, v25
    v_fmac_f32 v4, v24, v36
    v_fmac_f32 v5, v24, v37
    v_fmac_f32 v6, v24, v38
    v_fmac_f32 v8, v24, v39
    v_fmac_f32 v10, v26, v27
    v_fmac_f32 v4, v26, v40
    v_fmac_f32 v5, v26, v41
    v_fmac_f32 v6, v26, v42
    v_fmac_f32 v8, v26, v43
    s_cbranch_scc1 L_far
    buffer_store_dwordx4 v[4:7], v3, s[40:43], s54 offen
    buffer_store_dwordx4 v[8:11], v3, s[40:43], s54 offen offset:1024
    v_readfirstlane_b32 s34, v12
    s_mov_b32 s57, 15
    s_cmp_lg_u32 s34, 0
    s_cbranch_scc0 L_poll
    s_branch L_fin
L_far:
    buffer_store_dwordx4 v[4:7], v3, s[40:43], s54 offen sc1
    buffer_store_dwordx4 v[8:11], v3, s[40:43], s54 offen offset:1024 sc1
    s_branch L_fin
L_other:
    s_waitcnt lgkmcnt(0)
    v_readfirstlane_b32 s34, v12
    s_mov_b32 s57, 15
    s_cmp_lg_u32 s34, 0
    s_cbranch_scc1 L_fin
L_poll:
    s_bitcmp1_b32 s57, 0
    s_cbranch_scc0 L_pi0
    buffer_load_dwordx4 v[48:51], v99, s[40:43], 0 offen sc1
    buffer_load_dwordx4 v[52:55], v99, s[40:43], 0 offen offset:1024 sc1
L_pi0:
    s_bitcmp1_b32 s57, 1
    s_cbranch_scc0 L_pi1
    buffer_load_dwordx4 v[56:59], v99, s[40:43], s44 offen sc1
    buffer_load_dwordx4 v[60:63], v99, s[40:43], s44 offen offset:1024 sc1
L_pi1:
    s_bitcmp1_b32 s57, 2
    s_cbranch_scc0 L_pi2
    buffer_load_dwordx4 v[64:67], v99, s[40:43], s45 offen sc1
    buffer_load_dwordx4 v[68:71], v99, s[40:43], s45 offen offset:1024 sc1
L_pi2:
    s_bitcmp1_b32 s57, 3
    s_cbranch_scc0 L_pi3
    buffer_load_dwordx4 v[72:75], v99, s[40:43], s30 offen sc1
    buffer_load_dwordx4 v[76:79], v99, s[40:43], s30 offen offset:1024 sc1
L_pi3:
    s_sub_u32 s59, s59, 1
    s_cbranch_scc1 L_fin
    s_waitcnt vmcnt(0)
    v_cmp_ne_u32 s[24:25], v7, v51
    v_cmp_ne_u32 s[26:27], v7, v55
    v_cmp_ne_u32 s[28:29], v7, v59
    v_cmp_ne_u32 s[32:33], v7, v63
    v_cmp_ne_u32 s[34:35], v7, v67
    v_cmp_ne_u32 s[36:37], v7, v71
    v_cmp_ne_u32 s[38:39], v7, v75
    v_cmp_ne_u32 vcc, v7, v79
    s_or_b64 s[24:25], s[24:25], s[26:27]
    s_cselect_b32 s57, 1, 0
    s_or_b64 s[28:29], s[28:29], s[32:33]
    s_cselect_b32 s47, 2, 0
    s_or_b32 s57, s57, s47
    s_or_b64 s[34:35], s[34:35], s[36:37]
    s_cselect_b32 s47, 4, 0
    s_or_b32 s57, s57, s47
    s_or_b64 s[38:39], s[38:39], vcc
    s_cselect_b32 s47, 8, 0
    s_or_b32 s57, s57, s47
    s_cbranch_scc1 L_poll
L_final:
    v_max_f32 v14, v53, v61
    v_max3_f32 v14, v69, v77, v14
    v_mov_b32 v16, v14
    s_nop 1
    v_permlane32_swap_b32 v16, v14
    v_max_f32 v14, v16, v14
    v_mov_b32 v16, v14
    s_nop 1
    v_permlane16_swap_b32 v16, v14
    v_max_f32 v14, v16, v14
    v_sub_f32 v53, v53, v14
    v_sub_f32 v61, v61, v14
    v_sub_f32 v69, v69, v14
    v_sub_f32 v77, v77, v14
    v_exp_f32 v53, v53
    v_exp_f32 v61, v61
    v_exp_f32 v69, v69
    v_exp_f32 v77, v77
    v_mul_f32 v10, v53, v54
    v_mul_f32 v4, v53, v48
    v_mul_f32 v5, v53, v49
    v_mul_f32 v6, v53, v50
    v_mul_f32 v8, v53, v52
    v_fmac_f32 v10, v61, v62
    v_fmac_f32 v4, v61, v56
    v_fmac_f32 v5, v61, v57
    v_fmac_f32 v6, v61, v58
    v_fmac_f32 v8, v61, v60
    v_fmac_f32 v10, v69, v70
    v_fmac_f32 v4, v69, v64
    v_fmac_f32 v5, v69, v65
    v_fmac_f32 v6, v69, v66
    v_fmac_f32 v8, v69, v68
    v_fmac_f32 v10, v77, v78
    v_fmac_f32 v4, v77, v72
    v_fmac_f32 v5, v77, v73
    v_fmac_f32 v6, v77, v74
    v_fmac_f32 v8, v77, v76
    v_mov_b32 v16, v10
    v_permlane32_swap_b32 v4, v5
    v_permlane32_swap_b32 v6, v8
    v_permlane32_swap_b32 v16, v10
    v_add_f32 v4, v4, v5
    v_add_f32 v6, v6, v8
    v_add_f32 v10, v16, v10
    v_mov_b32 v16, v10
    v_permlane16_swap_b32 v4, v6
    s_nop 0
    v_permlane16_swap_b32 v16, v10
    v_add_f32 v10, v16, v10
    v_add_f32 v4, v4, v6
    v_rcp_f32 v10, v10
    s_nop 0
    v_mul_f32 v4, v4, v10
    v_cvt_pk_bf16_f32 v4, v4, v4
    global_store_short v96, v4, s[16:17]
    s_branch L_fin
L_elect:
    s_cmp_eq_u32 s56, 0
    s_cbranch_scc1 L_waittag
L_havetag:
    v_mov_b32 v7, s56
    v_mov_b32 v97, 1
    s_and_b32 s34, s56, 15
    s_xor_b32 s55, s34, s58
    s_sub_u32 s32, s32, 0x10000
    s_movk_i32 s44, 0x2000
    s_movk_i32 s45, 0x4000
    s_movk_i32 s30, 0x6000
    s_xor_b32 s34, s3, 1
    s_or_b32 s34, s34, s55
    s_cbranch_scc1 L_elected
    s_mul_i32 s34, s22, 12
    v_mov_b32 v5, s34
    s_mov_b64 exec, 1
    global_atomic_add v97, v5, v97, s[18:19] offset:64 sc0
    s_mov_b64 exec, -1
L_elected:
    s_branch L_v0
L_owner:
    s_lshl_b32 s54, s54, 4
    s_or_b32 s54, s54, s58
    s_bitset1_b32 s54, 31
    v_mov_b32 v40, s54
    s_mov_b64 exec, 1
    global_store_dword v91, v40, s[18:19] sc1
    s_mov_b64 exec, -1
    global_load_dwordx4 v[20:23], v42, s[10:11]
    global_load_dwordx2 v[24:25], v43, s[12:13]
    global_load_ushort v26, v83, s[14:15]
    s_branch L_start
L_tree:
    s_waitcnt vmcnt(4)
    v_mfma_f32_16x16x32_bf16 v[28:31], v[20:23], v[4:7], 0
    v_lshlrev_b32 v40, 16, v26
    v_sub_f32 v40, 1.0, v40
    v_mul_f32 v13, 0xceabfb8f, v40
    v_lshlrev_b32 v16, 16, v24
    v_and_b32 v17, 0xffff0000, v24
    v_lshlrev_b32 v18, 16, v25
    v_and_b32 v19, 0xffff0000, v25
    s_nop 0
    v_fmac_f32_dpp v13, v28, v12 quad_perm:[0,0,0,0] row_mask:0xf bank_mask:0xf
    s_nop 1
    v_fmac_f32_dpp v13, v29, v12 quad_perm:[1,1,1,1] row_mask:0xf bank_mask:0xf
    s_nop 1
    v_fmac_f32_dpp v13, v30, v12 quad_perm:[2,2,2,2] row_mask:0xf bank_mask:0xf
    s_nop 1
    v_fmac_f32_dpp v13, v31, v12 quad_perm:[3,3,3,3] row_mask:0xf bank_mask:0xf
    s_nop 1
    s_branch L_treedone
L_waittag:
    global_load_dword v7, v91, s[18:19] sc1
    s_waitcnt vmcnt(0)
    v_readfirstlane_b32 s56, v7
    s_sub_u32 s59, s59, 1
    s_cbranch_scc1 L_havetag
    s_cmp_eq_u32 s56, 0
    s_cbranch_scc1 L_waittag
    s_branch L_havetag
L_fin:
L_end:
    s_endpgm
.section .rodata,"a"
.p2align 6
.amdhsa_kernel standalone__tree_speculative_verify_tree_attention_over_candidate_token_tree__decode_kernel
  .amdhsa_next_free_vgpr 104
  .amdhsa_next_free_sgpr 60
  .amdhsa_accum_offset 104
  .amdhsa_group_segment_fixed_size 0
  .amdhsa_kernarg_size 72
  .amdhsa_user_sgpr_count 2
  .amdhsa_user_sgpr_kernarg_segment_ptr 1
  .amdhsa_system_sgpr_workgroup_id_x 1
  .amdhsa_float_denorm_mode_32 3
.end_amdhsa_kernel
```
